```python
import torch

def _softmax(x, axis=-1):
    return torch.softmax(x, dim=axis)
def _gelu(x):
    return torch.nn.functional.gelu(x, approximate="tanh")
def _silu(x):
    return torch.nn.functional.silu(x)
def _sigmoid(x):
    return torch.sigmoid(x)
def _layernorm(x, axis=-1, eps=1e-5):
    m = x.mean(dim=axis, keepdim=True)
    v = x.var(dim=axis, keepdim=True, unbiased=False)
    return (x - m) / torch.sqrt(v + eps)
def _scatter_add(tgt, idx, src, axis=0):
    return tgt.clone().index_add_(axis, idx, src)
def _segment_sum(src, seg, n):
    out = torch.zeros((n,) + src.shape[1:], dtype=src.dtype)
    return out.index_add_(0, seg, src)
def _pad(x, pw):
    flat = tuple(v for pair in reversed(pw) for v in pair)
    return torch.nn.functional.pad(x, flat)

kernel_name = 'standalone__glu_gated_swiglu__decode'

def setup_inputs():

    _w = (lambda a: (lambda t: t.to(torch.bfloat16) if t.is_floating_point() else t)(torch.as_tensor(a)))
    B, S, D, F = 8, 1, 1024, 3584
    return {
        "x": _w((lambda *s: torch.randn(*s, dtype=torch.bfloat16) * 0.05)(B, S, D)),
        "w1": _w((lambda *s: torch.randn(*s, dtype=torch.bfloat16) * 0.05)(D, F) * (2.0 / D) ** 0.5),
        "w3": _w((lambda *s: torch.randn(*s, dtype=torch.bfloat16) * 0.05)(D, F) * (2.0 / D) ** 0.5),
        "w2": _w((lambda *s: torch.randn(*s, dtype=torch.bfloat16) * 0.05)(F, D) * (2.0 / F) ** 0.5),
    }

def reference(x, w1, w3, w2):
    gate = torch.einsum("bsd,df->bsf", x, w1)
    up = torch.einsum("bsd,df->bsf", x, w3)
    h = _silu(gate) * up
    out = torch.einsum("bsf,fd->bsd", h, w2)
    return out
```

```asm
; @launch grid=(256,1,1) block=(320,1,1) lds=103488
.amdgcn_target "amdgcn-amd-amdhsa--gfx950"
.text
.globl standalone__glu_gated_swiglu__decode_kernel
.p2align 8
.type standalone__glu_gated_swiglu__decode_kernel,@function
standalone__glu_gated_swiglu__decode_kernel:
    s_load_dwordx8 s[4:11], s[0:1], 0
    s_load_dwordx4 s[48:51], s[0:1], 32
    s_load_dwordx2 s[52:53], s[0:1], 48
    s_and_b32 s3, s2, 24
    s_cbranch_scc1 L_nopf
    s_getpc_b64 s[20:21]
L_pc:
    v_lshlrev_b32 v5, 4, v0
    v_min_u32 v5, L_codeend-L_pc-4, v5
    global_load_dword v27, v5, s[20:21]
L_nopf:
    s_cmp_ge_u32 s2, 256
    s_cbranch_scc1 L_exit
    s_memrealtime s[36:37]
    v_lshrrev_b32 v1, 6, v0
    v_and_b32 v2, 63, v0
    v_readfirstlane_b32 s54, v1
    v_lshrrev_b32 v3, 4, v2
    v_and_b32 v4, 7, v2
    v_mov_b32 v25, 103424
    s_mov_b32 s60, 0
    s_and_b32 s12, s2, 7
    s_lshr_b32 s13, s2, 3
    s_add_u32 s14, s12, 3
    s_and_b32 s14, s14, 7
    s_cmp_eq_u32 s14, 7
    s_cselect_b32 s14, 3, s14
    s_lshr_b32 s15, s13, 2
    s_and_b32 s17, s13, 3
    s_cmp_eq_u32 s15, 7
    s_cselect_b32 s15, s14, s15
    s_cselect_b32 s19, 4, 0
    s_add_u32 s17, s17, s19
    s_mul_i32 s12, s12, 7
    s_add_u32 s16, s12, s15
    s_cmp_eq_u32 s15, s14
    s_cselect_b32 s18, 1, 0
    s_cmp_eq_u32 s54, 4
    s_cbranch_scc1 L_aux
    s_sub_u32 s20, 8, s18
    s_lshl_b32 s21, s17, s20
    v_lshl_add_u32 v5, v1, 2, v3
    v_add_u32 v5, s21, v5
    v_mul_u32_u24 v6, 7168, v5
    v_bfe_u32 v7, v2, 1, 3
    s_lshr_b32 s22, s54, 1
    s_lshl_b32 s22, s22, 2
    v_xor_b32 v7, v7, v3
    v_xor_b32 v7, s22, v7
    v_cmp_lt_u32 vcc, 3, v7
    v_and_b32 v7, 3, v7
    v_and_b32 v8, 1, v2
    v_lshl_add_u32 v6, v7, 5, v6
    v_lshl_add_u32 v6, v8, 4, v6
    s_lshl_b32 s23, s16, 7
    v_add_u32 v6, s23, v6
    s_lshl_b32 s20, s18, 7
    s_sub_u32 s21, s21, s20
    s_lshl_b32 s21, s21, 1
    v_lshrrev_b32 v9, 3, v0
    v_lshlrev_b32 v9, 4, v9
    v_lshl_add_u32 v9, v4, 11, v9
    v_add_u32 v9, s21, v9
    s_mov_b64 s[42:43], 114688
    s_lshl_b32 s38, s54, 10
    s_add_u32 m0, s38, 98304
    s_mov_b32 s30, 16384
    s_mov_b32 s31, 0x20000
    s_lshl_b32 s39, s18, 15
    s_cmp_eq_u32 s18, 1
    s_cselect_b32 s20, 7, 15
    s_or_b32 s21, s2, s54
    s_waitcnt lgkmcnt(0)
    s_cbranch_scc1 L_nonw
    s_or_b32 s37, s37, 0x80000000
    v_mov_b32 v10, s36
    v_mov_b32 v11, s37
    v_mov_b32 v8, 0
    s_mov_b64 exec, 1
    global_store_dwordx2 v8, v[10:11], s[50:51] sc1
    s_mov_b64 exec, -1
L_nonw:
    s_mov_b32 s28, s4
    s_mov_b32 s29, s5
    v_mov_b32 v10, s6
    v_mov_b32 v11, s7
    v_mov_b32 v7, s8
    v_mov_b32 v8, s9
    buffer_load_dwordx4 v9, s[28:31], 0 offen lds
    v_cndmask_b32 v10, v10, v7, vcc
    v_cndmask_b32 v11, v11, v8, vcc
    v_add_co_u32 v126, vcc, v10, v6
    s_add_u32 m0, s38, s39
    s_nop 0
    v_addc_co_u32 v127, vcc, 0, v11, vcc
L_i13:
    global_load_lds_dwordx4 v[126:127], off nt
    v_lshl_add_u64 v[126:127], v[126:127], 0, s[42:43]
    s_addk_i32 m0, 0x1000
    s_sub_u32 s20, s20, 1
    s_cbranch_scc0 L_i13
L_prec:
    v_lshrrev_b32 v5, 5, v2
    v_lshl_add_u32 v5, v1, 1, v5
    v_bfe_u32 v7, v2, 1, 4
    v_xor_b32 v7, v7, v5
    v_and_b32 v8, 1, v2
    v_lshlrev_b32 v24, 11, v5
    v_lshl_add_u32 v24, v7, 5, v24
    v_lshl_add_u32 v24, v8, 4, v24
    s_lshl_b32 s22, s16, 17
    s_lshl_b32 s21, s17, 9
    s_add_u32 s22, s22, s21
    s_mov_b32 s24, s10
    s_mov_b32 s25, s11
    s_cmp_lg_u32 s19, 0
    s_cselect_b32 s26, 0, 7340032
    s_mov_b32 s27, 0x20000
    s_mov_b32 s32, s52
    s_mov_b32 s33, s53
    s_mov_b32 s34, 8388608
    s_mov_b32 s35, 0x20000
    s_mov_b32 s56, 0xff00ff00
    s_mov_b32 s57, 0xff00ff00
    v_mov_b32 v20, 1023
    v_mov_b32 v21, 4095
    v_bfe_u32 v5, v2, 2, 2
    v_and_b32 v6, 3, v2
    v_and_b32 v7, 1, v3
    v_lshl_add_u32 v7, v7, 2, v5
    v_lshl_add_u32 v8, v3, 3, v5
    v_lshlrev_b32 v8, 8, v8
    v_lshl_add_u32 v8, v6, 3, v8
    v_add_u32 v8, s39, v8
    v_xor_b32 v9, v1, v7
    v_lshl_add_u32 v28, v9, 5, v8
    v_xor_b32 v29, 0x80, v28
    v_lshlrev_b32 v10, 4, v4
    v_lshl_add_u32 v30, v3, 7, v10
    s_lshr_b32 s20, s39, 4
    s_add_u32 s20, s20, 98304
    v_add_u32 v30, s20, v30
    v_lshrrev_b32 v8, 1, v3
    v_lshl_add_u32 v8, v8, 4, v7
    v_lshlrev_b32 v8, 9, v8
    v_lshl_add_u32 v8, v6, 3, v8
    v_add_u32 v8, 65536, v8
    v_lshlrev_b32 v9, 2, v1
    v_xor_b32 v9, v9, v7
    v_lshl_add_u32 v68, v9, 5, v8
    v_xor_b32 v69, 32, v68
    v_xor_b32 v70, 64, v68
    v_xor_b32 v71, 0x60, v68
    s_lshl_b32 s20, s16, 15
    v_lshlrev_b32 v11, 4, v2
    v_lshl_add_u32 v22, v1, 13, v11
    v_add_u32 v22, s20, v22
    s_lshl_b32 s71, s17, 10
    s_lshl_b32 s20, s18, 12
    s_add_u32 s20, s20, 0xfff
    s_add_u32 s64, s71, 1024
    s_and_b32 s64, s64, s20
    s_add_u32 s65, s64, 1024
    s_and_b32 s65, s65, s20
    s_add_u32 s66, s65, 1024
    s_and_b32 s66, s66, s20
    s_add_u32 s67, s66, 1024
    s_and_b32 s67, s67, s20
    s_add_u32 s68, s67, 1024
    s_and_b32 s68, s68, s20
    s_add_u32 s69, s68, 1024
    s_and_b32 s69, s69, s20
    s_add_u32 s70, s69, 1024
    s_and_b32 s70, s70, s20
    v_add_u32 v8, 102400, v10
    v_lshl_add_u32 v72, v3, 7, v8
    v_lshl_add_u32 v8, v1, 8, v8
    v_and_b32 v9, 1, v3
    v_lshl_add_u32 v8, v9, 7, v8
    v_lshrrev_b32 v9, 1, v3
    v_lshl_add_u32 v8, v9, 3, v8
    v_bfe_u32 v9, v2, 3, 1
    v_lshl_add_u32 v31, v9, 2, v8
    v_lshl_add_u32 v8, v1, 4, v3
    v_lshl_add_u32 v8, v9, 3, v8
    s_lshl_b32 s20, s17, 6
    v_add_u32 v8, s20, v8
    v_mul_u32_u24 v8, 7168, v8
    s_add_u32 s20, s23, 2097152
    v_add3_u32 v73, v8, v10, s20
    v_add_u32 v74, 28672, v73
    s_and_b32 s13, s2, 7
    s_lshl_b32 s13, s13, 5
    s_lshr_b32 s12, s2, 3
    s_add_u32 s13, s13, s12
    s_mul_i32 s12, s13, 7168
    s_add_u32 s12, s12, 2100224
    v_add_u32 v23, s12, v11
    s_lshl_b32 s12, s13, 2
    v_add_u32 v26, s12, v3
    v_lshl_add_u32 v26, v4, 10, v26
    v_lshlrev_b32 v26, 1, v26
    v_mov_b32 v60, 0
    v_mov_b32 v61, 0
    v_mov_b32 v62, 0
    v_mov_b32 v63, 0
    v_mov_b32 v64, 0
    v_mov_b32 v65, 0
    v_mov_b32 v66, 0
    v_mov_b32 v67, 0
    s_mov_b32 s21, 0
    s_lshl_b32 s44, s18, 1
L_pl:
    s_cmp_lt_u32 s21, s44
    s_cbranch_scc1 L_iss
    s_waitcnt vmcnt(12)
    s_barrier
    ds_read_b128 v[48:51], v30
    ds_read_b64_tr_b16 v[32:33], v28 offset:0
    ds_read_b64_tr_b16 v[34:35], v28 offset:1024
    ds_read_b64_tr_b16 v[36:37], v29 offset:0
    ds_read_b64_tr_b16 v[38:39], v29 offset:1024
    ds_read_b128 v[52:55], v30 offset:512
    ds_read_b64_tr_b16 v[40:41], v28 offset:8192
    ds_read_b64_tr_b16 v[42:43], v28 offset:9216
    ds_read_b64_tr_b16 v[44:45], v29 offset:8192
    ds_read_b64_tr_b16 v[46:47], v29 offset:9216
    v_add_u32 v28, 16384, v28
    v_add_u32 v29, 16384, v29
    v_add_u32 v30, 1024, v30
    s_cmp_eq_u32 s21, 2
    s_waitcnt lgkmcnt(5)
    v_mfma_f32_16x16x32_bf16 v[60:63], v[32:35], v[48:51], v[60:63]
    v_mfma_f32_16x16x32_bf16 v[64:67], v[36:39], v[48:51], v[64:67]
    s_waitcnt lgkmcnt(0)
    v_mfma_f32_16x16x32_bf16 v[60:63], v[40:43], v[52:55], v[60:63]
    v_mfma_f32_16x16x32_bf16 v[64:67], v[44:47], v[52:55], v[64:67]
    s_cbranch_scc1 L_pdone
L_iss:
    s_mov_b32 s20, 3
    s_add_u32 s21, s21, 1
L_i2:
    buffer_load_dwordx4 v24, s[24:27], s22 offen nt lds
    s_add_u32 s22, s22, 16384
    s_addk_i32 m0, 0x1000
    s_sub_u32 s20, s20, 1
    s_cbranch_scc0 L_i2
    s_branch L_pl
L_pdone:
    ds_read_b128 v[12:15], v25
    ds_read_b128 v[16:19], v25 offset:16
    ds_read_b128 v[48:51], v30
    ds_read_b128 v[52:55], v30 offset:512
    s_waitcnt vmcnt(10)
    s_barrier
    ds_read_b64_tr_b16 v[32:33], v28 offset:0
    ds_read_b64_tr_b16 v[34:35], v28 offset:1024
    ds_read_b64_tr_b16 v[36:37], v29 offset:0
    ds_read_b64_tr_b16 v[38:39], v29 offset:1024
    s_waitcnt lgkmcnt(0)
    v_mfma_f32_16x16x32_bf16 v[60:63], v[32:35], v[48:51], v[60:63]
    v_mfma_f32_16x16x32_bf16 v[64:67], v[36:39], v[48:51], v[64:67]
    s_waitcnt vmcnt(8)
    s_barrier
    ds_read_b64_tr_b16 v[40:41], v28 offset:8192
    ds_read_b64_tr_b16 v[42:43], v28 offset:9216
    ds_read_b64_tr_b16 v[44:45], v29 offset:8192
    ds_read_b64_tr_b16 v[46:47], v29 offset:9216
    s_waitcnt lgkmcnt(2)
    v_mfma_f32_16x16x32_bf16 v[60:63], v[40:43], v[52:55], v[60:63]
    s_waitcnt lgkmcnt(0)
    v_mfma_f32_16x16x32_bf16 v[64:67], v[44:47], v[52:55], v[64:67]
    s_cmp_eq_u32 s18, 1
    s_nop 6
    v_cndmask_b32 v8, v60, v64, s[56:57]
    v_cndmask_b32 v9, v61, v65, s[56:57]
    v_cndmask_b32 v10, v62, v66, s[56:57]
    v_cndmask_b32 v11, v63, v67, s[56:57]
    v_add_u32 v124, 512, v8
    v_add_u32 v125, 512, v9
    v_add_u32 v126, 512, v10
    v_add_u32 v127, 512, v11
    v_bfi_b32 v124, v20, v12, v124
    v_bfi_b32 v125, v20, v13, v125
    v_bfi_b32 v126, v20, v14, v126
    v_bfi_b32 v127, v20, v15, v127
    buffer_store_dwordx4 v[124:127], v22, s[32:35], s71 offen
    s_cbranch_scc0 L_g0
    buffer_load_dwordx4 v[44:47], v22, s[32:35], s67 offen sc1
    buffer_load_dwordx4 v[48:51], v22, s[32:35], s68 offen sc1
    buffer_load_dwordx4 v[52:55], v22, s[32:35], s69 offen sc1
    buffer_load_dwordx4 v[56:59], v22, s[32:35], s70 offen sc1
L_g0:
    buffer_load_dwordx4 v[32:35], v22, s[32:35], s64 offen sc1
    buffer_load_dwordx4 v[36:39], v22, s[32:35], s65 offen sc1
    buffer_load_dwordx4 v[40:43], v22, s[32:35], s66 offen sc1
    s_cbranch_scc0 L_gw
    s_waitcnt vmcnt(7)
    s_branch L_gw2
L_gw:
    s_waitcnt vmcnt(3)
L_gw2:
    s_cbranch_scc0 L_g1
    buffer_load_dwordx4 v[44:47], v22, s[32:35], s67 offen sc1
    buffer_load_dwordx4 v[48:51], v22, s[32:35], s68 offen sc1
    buffer_load_dwordx4 v[52:55], v22, s[32:35], s69 offen sc1
    buffer_load_dwordx4 v[56:59], v22, s[32:35], s70 offen sc1
L_g1:
    buffer_load_dwordx4 v[32:35], v22, s[32:35], s64 offen sc1
    buffer_load_dwordx4 v[36:39], v22, s[32:35], s65 offen sc1
    buffer_load_dwordx4 v[40:43], v22, s[32:35], s66 offen sc1
    s_barrier
    ds_read_b64_tr_b16 v[76:77], v68 offset:0
    ds_read_b64_tr_b16 v[78:79], v68 offset:4096
    ds_read_b64_tr_b16 v[80:81], v69 offset:0
    ds_read_b64_tr_b16 v[82:83], v69 offset:4096
    ds_read_b64_tr_b16 v[84:85], v70 offset:0
    ds_read_b64_tr_b16 v[86:87], v70 offset:4096
    ds_read_b64_tr_b16 v[88:89], v71 offset:0
    ds_read_b64_tr_b16 v[90:91], v71 offset:4096
    ds_read_b64_tr_b16 v[92:93], v68 offset:16384
    ds_read_b64_tr_b16 v[94:95], v68 offset:20480
    ds_read_b64_tr_b16 v[96:97], v69 offset:16384
    ds_read_b64_tr_b16 v[98:99], v69 offset:20480
    ds_read_b64_tr_b16 v[100:101], v70 offset:16384
    ds_read_b64_tr_b16 v[102:103], v70 offset:20480
    ds_read_b64_tr_b16 v[104:105], v71 offset:16384
    ds_read_b64_tr_b16 v[106:107], v71 offset:20480
L_poll1:
    s_waitcnt vmcnt(0)
    v_xor_b32 v32, v12, v32
    v_xor_b32 v33, v13, v33
    v_xor_b32 v34, v14, v34
    v_xor_b32 v35, v15, v35
    v_xor_b32 v36, v12, v36
    v_xor_b32 v37, v13, v37
    v_xor_b32 v38, v14, v38
    v_xor_b32 v39, v15, v39
    v_xor_b32 v40, v12, v40
    v_xor_b32 v41, v13, v41
    v_xor_b32 v42, v14, v42
    v_xor_b32 v43, v15, v43
    v_or3_b32 v5, v32, v33, v34
    v_or3_b32 v5, v5, v35, v36
    v_or3_b32 v5, v5, v37, v38
    v_or3_b32 v5, v5, v39, v40
    v_or3_b32 v5, v5, v41, v42
    v_or_b32 v5, v5, v43
    v_pk_add_f32 v[60:61], v[8:9], v[32:33]
    v_pk_add_f32 v[62:63], v[10:11], v[34:35]
    v_pk_add_f32 v[64:65], v[36:37], v[40:41]
    v_pk_add_f32 v[66:67], v[38:39], v[42:43]
    s_cbranch_scc1 L_more
L_hcalc:
    v_and_b32 v5, v20, v5
    v_pk_add_f32 v[60:61], v[60:61], v[64:65]
    v_pk_add_f32 v[62:63], v[62:63], v[66:67]
    v_cmp_ne_u32 vcc, 0, v5
    v_cvt_pk_bf16_f32 v6, v60, v61
    v_cvt_pk_bf16_f32 v7, v62, v63
    v_cvt_pk_bf16_f32 v5, v62, v63
    s_cbranch_vccnz L_retry1
    v_mov_b32_dpp v7, v6 row_ror:8 row_mask:0xf bank_mask:0x3
    v_mov_b32_dpp v6, v5 row_ror:8 row_mask:0xf bank_mask:0xc
    v_lshlrev_b32 v64, 16, v7
    v_and_b32 v65, 0xffff0000, v7
    v_lshlrev_b32 v60, 16, v6
    v_and_b32 v61, 0xffff0000, v6
    v_mul_f32 v62, 0xbfb8aa3b, v60
    v_mul_f32 v63, 0xbfb8aa3b, v61
    v_exp_f32 v62, v62
    v_exp_f32 v63, v63
    s_nop 0
    v_add_f32 v62, 1.0, v62
    v_add_f32 v63, 1.0, v63
    v_rcp_f32 v62, v62
    v_rcp_f32 v63, v63
    s_nop 0
    v_mul_f32 v62, v60, v62
    v_mul_f32 v63, v61, v63
    v_cvt_pk_bf16_f32 v6, v62, v63
    v_lshlrev_b32 v60, 16, v6
    v_and_b32 v61, 0xffff0000, v6
    v_mul_f32 v60, v60, v64
    v_mul_f32 v61, v61, v65
    v_cvt_pk_bf16_f32 v6, v60, v61
    ds_write_b32 v31, v6
    s_cmp_lg_u32 s19, 0
    s_waitcnt lgkmcnt(0)
    s_barrier
    ds_read_b128 v[60:63], v72
    ds_read_b128 v[64:67], v72 offset:512
    s_cbranch_scc1 L_extra
    s_waitcnt lgkmcnt(1)
    v_mfma_f32_16x16x32_bf16 v[108:111], v[76:79], v[60:63], 0
    v_mfma_f32_16x16x32_bf16 v[116:119], v[84:87], v[60:63], 0
    v_mfma_f32_16x16x32_bf16 v[112:115], v[80:83], v[60:63], 0
    v_mfma_f32_16x16x32_bf16 v[120:123], v[88:91], v[60:63], 0
    s_waitcnt lgkmcnt(0)
    v_mfma_f32_16x16x32_bf16 v[108:111], v[92:95], v[64:67], v[108:111]
    v_mfma_f32_16x16x32_bf16 v[116:119], v[100:103], v[64:67], v[116:119]
    v_mfma_f32_16x16x32_bf16 v[112:115], v[96:99], v[64:67], v[112:115]
    v_mfma_f32_16x16x32_bf16 v[120:123], v[104:107], v[64:67], v[120:123]
    s_cmp_lg_u32 s54, 0
    s_nop 4
    v_cndmask_b32 v108, v108, v116, s[56:57]
    v_cndmask_b32 v109, v109, v117, s[56:57]
    v_cndmask_b32 v110, v110, v118, s[56:57]
    v_cndmask_b32 v111, v111, v119, s[56:57]
    v_bfi_b32 v108, v21, v16, v108
    v_bfi_b32 v109, v21, v17, v109
    v_bfi_b32 v110, v21, v18, v110
    v_bfi_b32 v111, v21, v19, v111
    global_store_dwordx4 v73, v[108:111], s[52:53] sc1
    v_cndmask_b32 v112, v112, v120, s[56:57]
    v_cndmask_b32 v113, v113, v121, s[56:57]
    v_cndmask_b32 v114, v114, v122, s[56:57]
    v_cndmask_b32 v115, v115, v123, s[56:57]
    v_bfi_b32 v112, v21, v16, v112
    v_bfi_b32 v113, v21, v17, v113
    v_bfi_b32 v114, v21, v18, v114
    v_bfi_b32 v115, v21, v19, v115
    global_store_dwordx4 v74, v[112:115], s[52:53] sc1
    s_waitcnt vmcnt(0)
    s_cbranch_scc1 L_end
    s_barrier
L_poll2:
    global_load_dwordx4 v[32:35], v23, s[52:53] offset:-3072 sc1
    global_load_dwordx4 v[36:39], v23, s[52:53] offset:-2048 sc1
    global_load_dwordx4 v[40:43], v23, s[52:53] offset:-1024 sc1
    global_load_dwordx4 v[44:47], v23, s[52:53] offset:0 sc1
    global_load_dwordx4 v[48:51], v23, s[52:53] offset:1024 sc1
    global_load_dwordx4 v[52:55], v23, s[52:53] offset:2048 sc1
    global_load_dwordx4 v[56:59], v23, s[52:53] offset:3072 sc1
    s_waitcnt vmcnt(6)
    v_xor_b32 v32, v16, v32
    v_xor_b32 v33, v17, v33
    v_xor_b32 v34, v18, v34
    v_xor_b32 v35, v19, v35
    v_or3_b32 v5, v32, v33, v34
    v_or_b32 v5, v5, v35
    s_waitcnt vmcnt(5)
    v_xor_b32 v36, v16, v36
    v_xor_b32 v37, v17, v37
    v_xor_b32 v38, v18, v38
    v_xor_b32 v39, v19, v39
    v_or3_b32 v5, v5, v36, v37
    v_or3_b32 v5, v5, v38, v39
    v_pk_add_f32 v[8:9], v[32:33], v[36:37]
    v_pk_add_f32 v[10:11], v[34:35], v[38:39]
    s_waitcnt vmcnt(4)
    v_xor_b32 v40, v16, v40
    v_xor_b32 v41, v17, v41
    v_xor_b32 v42, v18, v42
    v_xor_b32 v43, v19, v43
    v_or3_b32 v5, v5, v40, v41
    v_or3_b32 v5, v5, v42, v43
    v_pk_add_f32 v[8:9], v[8:9], v[40:41]
    v_pk_add_f32 v[10:11], v[10:11], v[42:43]
    s_waitcnt vmcnt(3)
    v_xor_b32 v44, v16, v44
    v_xor_b32 v45, v17, v45
    v_xor_b32 v46, v18, v46
    v_xor_b32 v47, v19, v47
    v_or3_b32 v5, v5, v44, v45
    v_or3_b32 v5, v5, v46, v47
    v_pk_add_f32 v[8:9], v[8:9], v[44:45]
    v_pk_add_f32 v[10:11], v[10:11], v[46:47]
    s_waitcnt vmcnt(2)
    v_xor_b32 v48, v16, v48
    v_xor_b32 v49, v17, v49
    v_xor_b32 v50, v18, v50
    v_xor_b32 v51, v19, v51
    v_or3_b32 v5, v5, v48, v49
    v_or3_b32 v5, v5, v50, v51
    v_pk_add_f32 v[8:9], v[8:9], v[48:49]
    v_pk_add_f32 v[10:11], v[10:11], v[50:51]
    s_waitcnt vmcnt(1)
    v_xor_b32 v52, v16, v52
    v_xor_b32 v53, v17, v53
    v_xor_b32 v54, v18, v54
    v_xor_b32 v55, v19, v55
    v_or3_b32 v5, v5, v52, v53
    v_or3_b32 v5, v5, v54, v55
    v_pk_add_f32 v[8:9], v[8:9], v[52:53]
    v_pk_add_f32 v[10:11], v[10:11], v[54:55]
    s_waitcnt vmcnt(0)
    v_xor_b32 v56, v16, v56
    v_xor_b32 v57, v17, v57
    v_xor_b32 v58, v18, v58
    v_xor_b32 v59, v19, v59
    v_or3_b32 v5, v5, v56, v57
    v_or3_b32 v5, v5, v58, v59
    v_pk_add_f32 v[8:9], v[8:9], v[56:57]
    v_pk_add_f32 v[10:11], v[10:11], v[58:59]
    v_and_b32 v5, v21, v5
    v_cmp_ne_u32 vcc, 0, v5
    v_permlane32_swap_b32 v8, v10
    v_permlane32_swap_b32 v9, v11
    s_cbranch_vccnz L_retry2
    v_add_f32 v8, v8, v10
    v_add_f32 v9, v9, v11
    s_nop 1
    v_permlane16_swap_b32 v8, v9
    s_nop 0
    v_add_f32 v8, v8, v9
    s_nop 1
    v_add_f32_dpp v8, v8, v8 row_ror:8 row_mask:0xf bank_mask:0xf
    s_mov_b64 exec, s[56:57]
    v_cvt_pk_bf16_f32 v8, v8, v8
    global_store_short v26, v8, s[48:49]
L_end:
L_exit:
    s_endpgm
L_extra:
    s_cmp_lg_u32 s54, 0
    s_cbranch_scc1 L_exit
    s_sleep 26
    s_branch L_poll2
L_retry2:
    s_add_u32 s60, s60, 1
    s_cmp_lt_u32 s60, 0x400000
    s_cbranch_scc1 L_poll2
    s_endpgm
L_more:
    v_xor_b32 v44, v12, v44
    v_xor_b32 v45, v13, v45
    v_xor_b32 v46, v14, v46
    v_xor_b32 v47, v15, v47
    v_xor_b32 v48, v12, v48
    v_xor_b32 v49, v13, v49
    v_xor_b32 v50, v14, v50
    v_xor_b32 v51, v15, v51
    v_xor_b32 v52, v12, v52
    v_xor_b32 v53, v13, v53
    v_xor_b32 v54, v14, v54
    v_xor_b32 v55, v15, v55
    v_xor_b32 v56, v12, v56
    v_xor_b32 v57, v13, v57
    v_xor_b32 v58, v14, v58
    v_xor_b32 v59, v15, v59
    v_or3_b32 v5, v5, v44, v45
    v_or3_b32 v5, v5, v46, v47
    v_or3_b32 v5, v5, v48, v49
    v_or3_b32 v5, v5, v50, v51
    v_or3_b32 v5, v5, v52, v53
    v_or3_b32 v5, v5, v54, v55
    v_or3_b32 v5, v5, v56, v57
    v_or3_b32 v5, v5, v58, v59
    v_pk_add_f32 v[60:61], v[60:61], v[44:45]
    v_pk_add_f32 v[62:63], v[62:63], v[46:47]
    v_pk_add_f32 v[64:65], v[64:65], v[48:49]
    v_pk_add_f32 v[66:67], v[66:67], v[50:51]
    v_pk_add_f32 v[60:61], v[60:61], v[52:53]
    v_pk_add_f32 v[62:63], v[62:63], v[54:55]
    v_pk_add_f32 v[64:65], v[64:65], v[56:57]
    v_pk_add_f32 v[66:67], v[66:67], v[58:59]
    s_branch L_hcalc
L_aux:
    s_setprio 3
    v_mov_b32 v8, 0
    s_getreg_b32 s20, hwreg(HW_REG_XCC_ID)
    s_waitcnt lgkmcnt(0)
    s_sleep 10
    global_load_dwordx2 v[28:29], v8, s[50:51] sc1
    s_sleep 16
    global_load_dwordx2 v[30:31], v8, s[50:51] sc1
    s_and_b32 s20, s20, 7
    s_lshl_b32 s20, s20, 7
    s_cmp_eq_u32 s18, 1
    s_cbranch_scc1 L_aux0
    s_barrier
    s_barrier
L_aux0:
    s_waitcnt vmcnt(1)
    v_cmp_lt_i32 vcc, -1, v29
    s_cbranch_vccz L_aux2
L_aux1:
    s_waitcnt vmcnt(0)
    v_mov_b32 v28, v30
    v_mov_b32 v29, v31
    v_cmp_lt_i32 vcc, -1, v31
    s_cbranch_vccnz L_nretry
L_aux2:
    v_and_b32 v12, 1023, v28
    v_bfe_u32 v13, v28, 10, 10
    v_bfe_u32 v14, v28, 20, 10
    v_alignbit_b32 v5, v29, v28, 30
    v_and_b32 v5, 1023, v5
    v_xor_b32 v15, s20, v5
    v_and_b32 v16, 4095, v28
    v_bfe_u32 v17, v28, 12, 12
    v_alignbit_b32 v5, v29, v28, 24
    v_and_b32 v18, 4095, v5
    v_bfe_u32 v19, v29, 4, 12
    ds_write_b128 v25, v[12:15]
    ds_write_b128 v25, v[16:19] offset:16
    s_waitcnt lgkmcnt(0)
    s_endpgm
L_nretry:
    global_load_dwordx2 v[30:31], v8, s[50:51] sc1
    s_add_u32 s60, s60, 1
    s_cmp_lt_u32 s60, 0x400000
    s_cbranch_scc1 L_aux1
    s_endpgm
L_retry1:
    s_cmp_lt_u32 s60, 10
    s_cbranch_scc1 L_r1a
    s_getreg_b32 s20, hwreg(HW_REG_XCC_ID)
    s_and_b32 s20, s20, 7
    s_lshl_b32 s20, s20, 7
    v_xor_b32 v15, s20, v15
    v_xor_b32 v22, 4194304, v22
    s_cmp_eq_u32 s60, 10
    s_cbranch_scc0 L_r1a
    v_bfi_b32 v60, v20, v12, v124
    v_bfi_b32 v61, v20, v13, v125
    v_bfi_b32 v62, v20, v14, v126
    v_bfi_b32 v63, v20, v15, v127
    buffer_store_dwordx4 v[60:63], v22, s[32:35], s71 offen sc1
    s_waitcnt vmcnt(0)
L_r1a:
    s_add_u32 s60, s60, 1
    s_cmp_ge_u32 s60, 0x400000
    s_cbranch_scc1 L_exit
    s_cmp_eq_u32 s18, 1
    s_cbranch_scc0 L_r1b
    buffer_load_dwordx4 v[44:47], v22, s[32:35], s67 offen sc1
    buffer_load_dwordx4 v[48:51], v22, s[32:35], s68 offen sc1
    buffer_load_dwordx4 v[52:55], v22, s[32:35], s69 offen sc1
    buffer_load_dwordx4 v[56:59], v22, s[32:35], s70 offen sc1
L_r1b:
    buffer_load_dwordx4 v[32:35], v22, s[32:35], s64 offen sc1
    buffer_load_dwordx4 v[36:39], v22, s[32:35], s65 offen sc1
    buffer_load_dwordx4 v[40:43], v22, s[32:35], s66 offen sc1
    s_branch L_poll1
L_codeend:
.section .rodata,"a"
.p2align 6
.amdhsa_kernel standalone__glu_gated_swiglu__decode_kernel
  .amdhsa_next_free_vgpr 128
  .amdhsa_next_free_sgpr 100
  .amdhsa_accum_offset 128
  .amdhsa_group_segment_fixed_size 0
  .amdhsa_kernarg_size 56
  .amdhsa_user_sgpr_count 2
  .amdhsa_user_sgpr_kernarg_segment_ptr 1
  .amdhsa_system_sgpr_workgroup_id_x 1
  .amdhsa_float_denorm_mode_32 3
.end_amdhsa_kernel
```
